```python
import torch

def _softmax(x, axis=-1):
    return torch.softmax(x, dim=axis)
def _gelu(x):
    return torch.nn.functional.gelu(x, approximate="tanh")
def _silu(x):
    return torch.nn.functional.silu(x)
def _sigmoid(x):
    return torch.sigmoid(x)
def _layernorm(x, axis=-1, eps=1e-5):
    m = x.mean(dim=axis, keepdim=True)
    v = x.var(dim=axis, keepdim=True, unbiased=False)
    return (x - m) / torch.sqrt(v + eps)
def _scatter_add(tgt, idx, src, axis=0):
    return tgt.clone().index_add_(axis, idx, src)
def _segment_sum(src, seg, n):
    out = torch.zeros((n,) + src.shape[1:], dtype=src.dtype)
    return out.index_add_(0, seg, src)
def _pad(x, pw):
    flat = tuple(v for pair in reversed(pw) for v in pair)
    return torch.nn.functional.pad(x, flat)

kernel_name = 'standalone__geglu_ffn__prompt'

def setup_inputs():

    _w = (lambda a: (lambda t: t.to(torch.bfloat16) if t.is_floating_point() else t)(torch.as_tensor(a)))
    B, S, D, F = 1, 2048, 640, 1728
    return {
        "x": _w((lambda *s: torch.randn(*s, dtype=torch.bfloat16) * 0.05)(B, S, D)),
        "w_gate": _w((lambda *s: torch.randn(*s, dtype=torch.bfloat16) * 0.05)(D, F)),
        "w_up": _w((lambda *s: torch.randn(*s, dtype=torch.bfloat16) * 0.05)(D, F)),
        "w_down": _w((lambda *s: torch.randn(*s, dtype=torch.bfloat16) * 0.05)(F, D)),
    }

def reference(x, w_gate, w_up, w_down):
    return (_gelu(x @ w_gate) * (x @ w_up)) @ w_down
```

```asm
; @launch kernel=geglu_k1_kernel grid=(256,1,1) block=(512,1,1) lds=135168
; @launch kernel=geglu_k2_kernel grid=(256,1,1) block=(512,1,1) lds=147456
.amdgcn_target "amdgcn-amd-amdhsa--gfx950"
.text
    .globl geglu_k1_kernel
    .p2align 8
    .type geglu_k1_kernel,@function
geglu_k1_kernel:
    s_cmp_ge_u32 s2, 256
    s_cbranch_scc1 L1_end
    s_load_dwordx4 s[4:7], s[0:1], 0
    s_load_dwordx4 s[28:31], s[0:1], 16
    s_load_dwordx2 s[52:53], s[0:1], 48
    v_lshrrev_b32 v1, 6, v0
    v_and_b32 v2, 63, v0
    v_lshlrev_b32 v3, 7, v2
    v_readfirstlane_b32 s40, v1
    s_mov_b32 s63, 0x00020000
    s_lshl_b32 s44, s40, 8
    s_add_u32 s44, s44, s2
    s_sub_u32 s45, s44, 320
    s_sub_u32 s46, s44, 590
    s_waitcnt lgkmcnt(0)
    s_mov_b32 s60, s4
    s_mov_b32 s61, s5
    s_mov_b32 s62, 2621440
    s_cmp_ge_u32 s44, 320
    s_cselect_b32 s60, s6, s60
    s_cselect_b32 s61, s7, s61
    s_cselect_b32 s62, 2211840, s62
    s_cselect_b32 s47, s45, s44
    s_cmp_ge_u32 s44, 590
    s_cselect_b32 s60, s28, s60
    s_cselect_b32 s61, s29, s61
    s_cselect_b32 s47, s46, s47
    s_and_b32 s61, s61, 0xffff
    s_lshl_b32 s47, s47, 13
    buffer_load_dword v216, v3, s[60:63], s47 offen
    s_and_b32 s32, s2, 7
    s_lshr_b32 s33, s2, 3
    s_lshr_b32 s34, s32, 2
    s_and_b32 s35, s32, 3
    s_and_b32 s36, s33, 7
    s_lshl_b32 s34, s34, 3
    s_add_u32 s34, s34, s36
    s_lshr_b32 s36, s33, 3
    s_lshl_b32 s35, s35, 2
    s_add_u32 s35, s35, s36
    s_mul_i32 s36, s35, 27
    s_lshr_b32 s36, s36, 2
    s_lshl_b32 s37, s36, 5
    s_lshl_b32 s38, s34, 7
    s_mov_b32 s8, s4
    s_and_b32 s9, s5, 0xffff
    s_mov_b32 s10, 2621440
    s_mov_b32 s11, 0x00020000
    s_mov_b32 s12, s6
    s_and_b32 s13, s7, 0xffff
    s_mov_b32 s14, 2211840
    s_mov_b32 s15, 0x00020000
    s_mov_b32 s16, s28
    s_and_b32 s17, s29, 0xffff
    s_mov_b32 s18, 2211840
    s_mov_b32 s19, 0x00020000
    s_mov_b32 s20, s52
    s_and_b32 s21, s53, 0xffff
    s_mov_b32 s22, 7077888
    s_mov_b32 s23, 0x00020000
    s_mov_b32 s3, 45056
    s_cmp_lt_u32 s40, 4
    s_cbranch_scc1 L1_compute
    s_sub_u32 s41, s40, 4
    s_lshr_b32 s42, s41, 1
    s_and_b32 s43, s41, 1
    s_cmp_eq_u32 s42, 0
    s_cselect_b32 s24, s12, s16
    s_cselect_b32 s25, s13, s17
    s_mov_b32 s26, 2211840
    s_mov_b32 s27, 0x00020000
    v_lshrrev_b32 v3, 3, v2
    v_and_b32 v4, 7, v2
    v_lshrrev_b32 v5, 4, v2
    s_lshl_b32 s44, s41, 5
    s_add_u32 s44, s44, s38
    v_add_u32 v3, s44, v3
    v_mov_b32 v6, 0x500
    v_mul_lo_u32 v3, v3, v6
    v_xor_b32 v6, v4, v5
    v_lshlrev_b32 v6, 4, v6
    v_add_u32 v16, v3, v6
    v_xor_b32 v6, 64, v6
    v_add_u32 v17, v3, v6
    v_add_u32 v17, 10240, v17
    v_add_u32 v18, 20480, v16
    v_add_u32 v19, 20480, v17
    s_mul_i32 s44, s43, 448
    s_lshl_b32 s45, s41, 12
    s_mul_i32 s46, s42, 14336
    s_mul_i32 s47, s43, 7168
    s_add_u32 s46, s46, s47
    s_add_u32 s46, s46, 16384
    s_mov_b32 s48, 0
    s_mov_b32 s49, 0
    s_mov_b32 s54, 0
    v_add_u32 v3, 0, v2
    v_add_u32 v3, s44, v3
    v_mul_u32_u24 v4, 4682, v3
    v_lshrrev_b32 v4, 16, v4
    v_mul_u32_u24 v5, 14, v4
    v_sub_u32 v5, v3, v5
    v_and_b32 v6, 0x33, v4
    v_bfe_u32 v7, v4, 2, 1
    v_lshl_add_u32 v6, v7, 3, v6
    v_bfe_u32 v7, v4, 3, 1
    v_lshl_add_u32 v6, v7, 2, v6
    v_mul_u32_u24 v6, 0xd80, v6
    v_lshl_add_u32 v6, v5, 4, v6
    v_add_u32 v20, s37, v6
    v_add_u32 v3, 64, v2
    v_add_u32 v3, s44, v3
    v_mul_u32_u24 v4, 4682, v3
    v_lshrrev_b32 v4, 16, v4
    v_mul_u32_u24 v5, 14, v4
    v_sub_u32 v5, v3, v5
    v_and_b32 v6, 0x33, v4
    v_bfe_u32 v7, v4, 2, 1
    v_lshl_add_u32 v6, v7, 3, v6
    v_bfe_u32 v7, v4, 3, 1
    v_lshl_add_u32 v6, v7, 2, v6
    v_mul_u32_u24 v6, 0xd80, v6
    v_lshl_add_u32 v6, v5, 4, v6
    v_add_u32 v21, s37, v6
    v_add_u32 v3, 128, v2
    v_add_u32 v3, s44, v3
    v_mul_u32_u24 v4, 4682, v3
    v_lshrrev_b32 v4, 16, v4
    v_mul_u32_u24 v5, 14, v4
    v_sub_u32 v5, v3, v5
    v_and_b32 v6, 0x33, v4
    v_bfe_u32 v7, v4, 2, 1
    v_lshl_add_u32 v6, v7, 3, v6
    v_bfe_u32 v7, v4, 3, 1
    v_lshl_add_u32 v6, v7, 2, v6
    v_mul_u32_u24 v6, 0xd80, v6
    v_lshl_add_u32 v6, v5, 4, v6
    v_add_u32 v22, s37, v6
    v_add_u32 v3, 192, v2
    v_add_u32 v3, s44, v3
    v_mul_u32_u24 v4, 4682, v3
    v_lshrrev_b32 v4, 16, v4
    v_mul_u32_u24 v5, 14, v4
    v_sub_u32 v5, v3, v5
    v_and_b32 v6, 0x33, v4
    v_bfe_u32 v7, v4, 2, 1
    v_lshl_add_u32 v6, v7, 3, v6
    v_bfe_u32 v7, v4, 3, 1
    v_lshl_add_u32 v6, v7, 2, v6
    v_mul_u32_u24 v6, 0xd80, v6
    v_lshl_add_u32 v6, v5, 4, v6
    v_add_u32 v23, s37, v6
    v_add_u32 v3, 256, v2
    v_add_u32 v3, s44, v3
    v_mul_u32_u24 v4, 4682, v3
    v_lshrrev_b32 v4, 16, v4
    v_mul_u32_u24 v5, 14, v4
    v_sub_u32 v5, v3, v5
    v_and_b32 v6, 0x33, v4
    v_bfe_u32 v7, v4, 2, 1
    v_lshl_add_u32 v6, v7, 3, v6
    v_bfe_u32 v7, v4, 3, 1
    v_lshl_add_u32 v6, v7, 2, v6
    v_mul_u32_u24 v6, 0xd80, v6
    v_lshl_add_u32 v6, v5, 4, v6
    v_add_u32 v24, s37, v6
    v_add_u32 v3, 320, v2
    v_add_u32 v3, s44, v3
    v_mul_u32_u24 v4, 4682, v3
    v_lshrrev_b32 v4, 16, v4
    v_mul_u32_u24 v5, 14, v4
    v_sub_u32 v5, v3, v5
    v_and_b32 v6, 0x33, v4
    v_bfe_u32 v7, v4, 2, 1
    v_lshl_add_u32 v6, v7, 3, v6
    v_bfe_u32 v7, v4, 3, 1
    v_lshl_add_u32 v6, v7, 2, v6
    v_mul_u32_u24 v6, 0xd80, v6
    v_lshl_add_u32 v6, v5, 4, v6
    v_add_u32 v25, s37, v6
    v_add_u32 v3, 384, v2
    v_add_u32 v3, s44, v3
    v_mul_u32_u24 v4, 4682, v3
    v_lshrrev_b32 v4, 16, v4
    v_mul_u32_u24 v5, 14, v4
    v_sub_u32 v5, v3, v5
    v_and_b32 v6, 0x33, v4
    v_bfe_u32 v7, v4, 2, 1
    v_lshl_add_u32 v6, v7, 3, v6
    v_bfe_u32 v7, v4, 3, 1
    v_lshl_add_u32 v6, v7, 2, v6
    v_mul_u32_u24 v6, 0xd80, v6
    v_lshl_add_u32 v6, v5, 4, v6
    v_add_u32 v26, s37, v6
    s_add_u32 m0, s45, 0
    s_nop 0
    buffer_load_dwordx4 v16, s[8:11], s48 offen lds
    s_add_u32 m0, s45, 1024
    s_nop 0
    buffer_load_dwordx4 v17, s[8:11], s48 offen lds
    s_add_u32 m0, s45, 2048
    s_nop 0
    buffer_load_dwordx4 v18, s[8:11], s48 offen lds
    s_add_u32 m0, s45, 3072
    s_nop 0
    buffer_load_dwordx4 v19, s[8:11], s48 offen lds
    s_add_u32 m0, s46, 0
    s_nop 0
    buffer_load_dwordx4 v20, s[24:27], s49 offen lds
    s_add_u32 m0, s46, 1024
    s_nop 0
    buffer_load_dwordx4 v21, s[24:27], s49 offen lds
    s_add_u32 m0, s46, 2048
    s_nop 0
    buffer_load_dwordx4 v22, s[24:27], s49 offen lds
    s_add_u32 m0, s46, 3072
    s_nop 0
    buffer_load_dwordx4 v23, s[24:27], s49 offen lds
    s_add_u32 m0, s46, 4096
    s_nop 0
    buffer_load_dwordx4 v24, s[24:27], s49 offen lds
    s_add_u32 m0, s46, 5120
    s_nop 0
    buffer_load_dwordx4 v25, s[24:27], s49 offen lds
    s_add_u32 m0, s46, 6144
    s_nop 0
    buffer_load_dwordx4 v26, s[24:27], s49 offen lds
    s_add_u32 s48, s48, 128
    s_add_u32 s49, s49, 221184
    s_add_u32 s54, s54, 1
    s_cmp_eq_u32 s54, 3
    s_cselect_b32 s55, -90112, s3
    s_cselect_b32 s54, 0, s54
    s_add_u32 s45, s45, s55
    s_add_u32 s46, s46, s55
    s_mov_b32 s60, s30
    s_and_b32 s61, s31, 0xffff
    s_mov_b32 s62, 2211840
    s_mov_b32 s63, 0x00020000
    s_add_u32 s56, s52, 8388608
    s_addc_u32 s57, s53, 0
    s_and_b32 s57, s57, 0xffff
    s_mov_b32 s58, 2211840
    s_mov_b32 s59, 0x00020000
    s_lshl_b32 s50, s2, 3
    s_lshl_b32 s51, s41, 1
    s_add_u32 s50, s50, s51
    v_add_u32 v3, 0, v2
    v_cmp_le_u32 vcc, 80, v3
    s_nop 1
    v_cndmask_b32 v4, 0, 1, vcc
    v_mul_u32_u24 v5, 80, v4
    v_sub_u32 v5, v3, v5
    v_add_u32 v4, s50, v4
    v_mul_u32_u24 v6, 0x500, v4
    v_lshl_add_u32 v30, v5, 4, v6
    v_mul_u32_u24 v6, 6554, v5
    v_lshrrev_b32 v6, 16, v6
    v_mul_u32_u24 v7, 10, v6
    v_sub_u32 v7, v5, v7
    v_mov_b32 v8, 276480
    v_mul_lo_u32 v6, v6, v8
    v_lshl_add_u32 v6, v7, 4, v6
    v_and_b32 v7, 0xfffffff3, v4
    v_bfe_u32 v8, v4, 2, 1
    v_lshl_add_u32 v7, v8, 3, v7
    v_bfe_u32 v8, v4, 3, 1
    v_lshl_add_u32 v7, v8, 2, v7
    v_mul_u32_u24 v7, 160, v7
    v_add_u32 v33, v6, v7
    v_add_u32 v3, 64, v2
    v_cmp_le_u32 vcc, 80, v3
    s_nop 1
    v_cndmask_b32 v4, 0, 1, vcc
    v_mul_u32_u24 v5, 80, v4
    v_sub_u32 v5, v3, v5
    v_add_u32 v4, s50, v4
    v_mul_u32_u24 v6, 0x500, v4
    v_lshl_add_u32 v31, v5, 4, v6
    v_mul_u32_u24 v6, 6554, v5
    v_lshrrev_b32 v6, 16, v6
    v_mul_u32_u24 v7, 10, v6
    v_sub_u32 v7, v5, v7
    v_mov_b32 v8, 276480
    v_mul_lo_u32 v6, v6, v8
    v_lshl_add_u32 v6, v7, 4, v6
    v_and_b32 v7, 0xfffffff3, v4
    v_bfe_u32 v8, v4, 2, 1
    v_lshl_add_u32 v7, v8, 3, v7
    v_bfe_u32 v8, v4, 3, 1
    v_lshl_add_u32 v7, v8, 2, v7
    v_mul_u32_u24 v7, 160, v7
    v_add_u32 v34, v6, v7
    v_add_u32 v3, 128, v2
    v_cmp_le_u32 vcc, 80, v3
    s_nop 1
    v_cndmask_b32 v4, 0, 1, vcc
    v_mul_u32_u24 v5, 80, v4
    v_sub_u32 v5, v3, v5
    v_add_u32 v4, s50, v4
    v_mul_u32_u24 v6, 0x500, v4
    v_lshl_add_u32 v32, v5, 4, v6
    v_mul_u32_u24 v6, 6554, v5
    v_lshrrev_b32 v6, 16, v6
    v_mul_u32_u24 v7, 10, v6
    v_sub_u32 v7, v5, v7
    v_mov_b32 v8, 276480
    v_mul_lo_u32 v6, v6, v8
    v_lshl_add_u32 v6, v7, 4, v6
    v_and_b32 v7, 0xfffffff3, v4
    v_bfe_u32 v8, v4, 2, 1
    v_lshl_add_u32 v7, v8, 3, v7
    v_bfe_u32 v8, v4, 3, 1
    v_lshl_add_u32 v7, v8, 2, v7
    v_mul_u32_u24 v7, 160, v7
    v_add_u32 v35, v6, v7
    v_cmp_le_u32 vcc, 32, v2
    v_mov_b32 v3, 0x10000000
    s_mov_b32 s51, 0
    s_cmp_ge_u32 s2, 216
    s_cselect_b32 s51, 0x10000000, s51
    v_cndmask_b32 v32, v32, v3, vcc
    v_cndmask_b32 v35, v35, v3, vcc
    v_or_b32 v33, s51, v33
    v_or_b32 v34, s51, v34
    v_or_b32 v35, s51, v35
    buffer_load_dwordx4 v[40:43], v30, s[60:63], 0 offen
    buffer_load_dwordx4 v[44:47], v31, s[60:63], 0 offen
    buffer_load_dwordx4 v[48:51], v32, s[60:63], 0 offen
    s_waitcnt vmcnt(3)
    s_barrier
    s_add_u32 m0, s45, 0
    s_nop 0
    buffer_load_dwordx4 v16, s[8:11], s48 offen lds
    s_add_u32 m0, s45, 1024
    s_nop 0
    buffer_load_dwordx4 v17, s[8:11], s48 offen lds
    s_add_u32 m0, s45, 2048
    s_nop 0
    buffer_load_dwordx4 v18, s[8:11], s48 offen lds
    s_add_u32 m0, s45, 3072
    s_nop 0
    buffer_load_dwordx4 v19, s[8:11], s48 offen lds
    s_add_u32 m0, s46, 0
    s_nop 0
    buffer_load_dwordx4 v20, s[24:27], s49 offen lds
    s_add_u32 m0, s46, 1024
    s_nop 0
    buffer_load_dwordx4 v21, s[24:27], s49 offen lds
    s_add_u32 m0, s46, 2048
    s_nop 0
    buffer_load_dwordx4 v22, s[24:27], s49 offen lds
    s_add_u32 m0, s46, 3072
    s_nop 0
    buffer_load_dwordx4 v23, s[24:27], s49 offen lds
    s_add_u32 m0, s46, 4096
    s_nop 0
    buffer_load_dwordx4 v24, s[24:27], s49 offen lds
    s_add_u32 m0, s46, 5120
    s_nop 0
    buffer_load_dwordx4 v25, s[24:27], s49 offen lds
    s_add_u32 m0, s46, 6144
    s_nop 0
    buffer_load_dwordx4 v26, s[24:27], s49 offen lds
    s_add_u32 s48, s48, 128
    s_add_u32 s49, s49, 221184
    s_add_u32 s54, s54, 1
    s_cmp_eq_u32 s54, 3
    s_cselect_b32 s55, -90112, s3
    s_cselect_b32 s54, 0, s54
    s_add_u32 s45, s45, s55
    s_add_u32 s46, s46, s55
    s_mov_b32 s39, 0
L1_lloop:
    s_add_u32 m0, s45, 0
    s_nop 0
    buffer_load_dwordx4 v16, s[8:11], s48 offen lds
    s_add_u32 m0, s45, 1024
    s_nop 0
    buffer_load_dwordx4 v17, s[8:11], s48 offen lds
    s_add_u32 m0, s45, 2048
    s_nop 0
    buffer_load_dwordx4 v18, s[8:11], s48 offen lds
    s_add_u32 m0, s45, 3072
    s_nop 0
    buffer_load_dwordx4 v19, s[8:11], s48 offen lds
    s_add_u32 m0, s46, 0
    s_nop 0
    buffer_load_dwordx4 v20, s[24:27], s49 offen lds
    s_add_u32 m0, s46, 1024
    s_nop 0
    buffer_load_dwordx4 v21, s[24:27], s49 offen lds
    s_add_u32 m0, s46, 2048
    s_nop 0
    buffer_load_dwordx4 v22, s[24:27], s49 offen lds
    s_add_u32 m0, s46, 3072
    s_nop 0
    buffer_load_dwordx4 v23, s[24:27], s49 offen lds
    s_add_u32 m0, s46, 4096
    s_nop 0
    buffer_load_dwordx4 v24, s[24:27], s49 offen lds
    s_add_u32 m0, s46, 5120
    s_nop 0
    buffer_load_dwordx4 v25, s[24:27], s49 offen lds
    s_add_u32 m0, s46, 6144
    s_nop 0
    buffer_load_dwordx4 v26, s[24:27], s49 offen lds
    s_add_u32 s48, s48, 128
    s_add_u32 s49, s49, 221184
    s_add_u32 s54, s54, 1
    s_cmp_eq_u32 s54, 3
    s_cselect_b32 s55, -90112, s3
    s_cselect_b32 s54, 0, s54
    s_add_u32 s45, s45, s55
    s_add_u32 s46, s46, s55
    s_waitcnt vmcnt(11)
    s_barrier
    s_add_u32 s39, s39, 1
    s_cmp_lt_u32 s39, 8
    s_cbranch_scc1 L1_lloop
    s_waitcnt vmcnt(0)
    s_barrier
    buffer_store_dwordx4 v[40:43], v33, s[56:59], 0 offen sc1
    buffer_store_dwordx4 v[44:47], v34, s[56:59], 0 offen sc1
    buffer_store_dwordx4 v[48:51], v35, s[56:59], 0 offen sc1
    s_branch L1_epi
L1_compute:
    s_and_b32 s41, s40, 1
    s_lshr_b32 s42, s40, 1
    v_and_b32 v3, 15, v2
    v_lshrrev_b32 v4, 4, v2
    v_lshrrev_b32 v5, 1, v3
    s_lshl_b32 s43, s41, 13
    v_lshlrev_b32 v6, 7, v3
    v_add_u32 v6, s43, v6
    v_xor_b32 v7, v4, v5
    v_lshlrev_b32 v7, 4, v7
    v_add_u32 v8, v6, v7
    v_xor_b32 v9, 64, v8
    v_lshrrev_b32 v5, 1, v4
    v_lshlrev_b32 v5, 4, v5
    v_and_b32 v6, 1, v4
    v_lshl_add_u32 v5, v6, 2, v5
    v_bfe_u32 v6, v2, 2, 2
    v_add_u32 v5, v5, v6
    v_mul_u32_u24 v5, 224, v5
    v_and_b32 v6, 3, v2
    v_lshl_add_u32 v5, v6, 3, v5
    s_mul_i32 s43, s42, 14336
    s_add_u32 s43, s43, 16384
    v_add_u32 v10, s43, v5
    s_lshl_b32 s43, s41, 6
    v_add_u32 v3, s43, v3
    v_mul_u32_u24 v3, 240, v3
    v_lshl_add_u32 v3, v4, 3, v3
    s_mul_i32 s43, s42, 30720
    s_add_u32 s43, s43, 45056
    v_add_u32 v3, s43, v3
    s_mov_b32 s54, 0
    s_mov_b32 s39, 1
    s_barrier
    ds_read_b128 v[16:19], v8 offset:0
    ds_read_b128 v[20:23], v8 offset:2048
    ds_read_b128 v[24:27], v8 offset:4096
    ds_read_b128 v[28:31], v8 offset:6144
    ds_read_b64_tr_b16 v[48:49], v10 offset:0
    ds_read_b64_tr_b16 v[50:51], v10 offset:1792
    ds_read_b64_tr_b16 v[52:53], v10 offset:32
    ds_read_b64_tr_b16 v[54:55], v10 offset:1824
    ds_read_b64_tr_b16 v[56:57], v10 offset:64
    ds_read_b64_tr_b16 v[58:59], v10 offset:1856
    ds_read_b64_tr_b16 v[60:61], v10 offset:96
    ds_read_b64_tr_b16 v[62:63], v10 offset:1888
    ds_read_b64_tr_b16 v[64:65], v10 offset:128
    ds_read_b64_tr_b16 v[66:67], v10 offset:1920
    ds_read_b64_tr_b16 v[68:69], v10 offset:160
    ds_read_b64_tr_b16 v[70:71], v10 offset:1952
    ds_read_b64_tr_b16 v[72:73], v10 offset:192
    ds_read_b64_tr_b16 v[74:75], v10 offset:1984
    ds_read_b128 v[32:35], v9 offset:0
    ds_read_b128 v[36:39], v9 offset:2048
    ds_read_b128 v[40:43], v9 offset:4096
    ds_read_b128 v[44:47], v9 offset:6144
    ds_read_b64_tr_b16 v[76:77], v10 offset:7168
    ds_read_b64_tr_b16 v[78:79], v10 offset:8960
    ds_read_b64_tr_b16 v[80:81], v10 offset:7200
    ds_read_b64_tr_b16 v[82:83], v10 offset:8992
    ds_read_b64_tr_b16 v[84:85], v10 offset:7232
    ds_read_b64_tr_b16 v[86:87], v10 offset:9024
    ds_read_b64_tr_b16 v[88:89], v10 offset:7264
    ds_read_b64_tr_b16 v[90:91], v10 offset:9056
    ds_read_b64_tr_b16 v[92:93], v10 offset:7296
    ds_read_b64_tr_b16 v[94:95], v10 offset:9088
    ds_read_b64_tr_b16 v[96:97], v10 offset:7328
    ds_read_b64_tr_b16 v[98:99], v10 offset:9120
    ds_read_b64_tr_b16 v[100:101], v10 offset:7360
    ds_read_b64_tr_b16 v[102:103], v10 offset:9152
    s_waitcnt lgkmcnt(15)
    v_mfma_f32_16x16x32_bf16 v[104:107], v[48:51], v[16:19], 0
    v_mfma_f32_16x16x32_bf16 v[132:135], v[48:51], v[20:23], 0
    v_mfma_f32_16x16x32_bf16 v[160:163], v[48:51], v[24:27], 0
    v_mfma_f32_16x16x32_bf16 v[188:191], v[48:51], v[28:31], 0
    v_mfma_f32_16x16x32_bf16 v[108:111], v[52:55], v[16:19], 0
    v_mfma_f32_16x16x32_bf16 v[136:139], v[52:55], v[20:23], 0
    v_mfma_f32_16x16x32_bf16 v[164:167], v[52:55], v[24:27], 0
    v_mfma_f32_16x16x32_bf16 v[192:195], v[52:55], v[28:31], 0
    v_mfma_f32_16x16x32_bf16 v[112:115], v[56:59], v[16:19], 0
    v_mfma_f32_16x16x32_bf16 v[140:143], v[56:59], v[20:23], 0
    v_mfma_f32_16x16x32_bf16 v[168:171], v[56:59], v[24:27], 0
    v_mfma_f32_16x16x32_bf16 v[196:199], v[56:59], v[28:31], 0
    v_mfma_f32_16x16x32_bf16 v[116:119], v[60:63], v[16:19], 0
    v_mfma_f32_16x16x32_bf16 v[144:147], v[60:63], v[20:23], 0
    v_mfma_f32_16x16x32_bf16 v[172:175], v[60:63], v[24:27], 0
    v_mfma_f32_16x16x32_bf16 v[200:203], v[60:63], v[28:31], 0
    v_mfma_f32_16x16x32_bf16 v[120:123], v[64:67], v[16:19], 0
    v_mfma_f32_16x16x32_bf16 v[148:151], v[64:67], v[20:23], 0
    v_mfma_f32_16x16x32_bf16 v[176:179], v[64:67], v[24:27], 0
    v_mfma_f32_16x16x32_bf16 v[204:207], v[64:67], v[28:31], 0
    v_mfma_f32_16x16x32_bf16 v[124:127], v[68:71], v[16:19], 0
    v_mfma_f32_16x16x32_bf16 v[152:155], v[68:71], v[20:23], 0
    v_mfma_f32_16x16x32_bf16 v[180:183], v[68:71], v[24:27], 0
    v_mfma_f32_16x16x32_bf16 v[208:211], v[68:71], v[28:31], 0
    v_mfma_f32_16x16x32_bf16 v[128:131], v[72:75], v[16:19], 0
    v_mfma_f32_16x16x32_bf16 v[156:159], v[72:75], v[20:23], 0
    v_mfma_f32_16x16x32_bf16 v[184:187], v[72:75], v[24:27], 0
    v_mfma_f32_16x16x32_bf16 v[212:215], v[72:75], v[28:31], 0
L1_cloop:
    s_add_u32 s54, s54, 1
    s_cmp_eq_u32 s54, 3
    s_cselect_b32 s55, -90112, s3
    s_cselect_b32 s54, 0, s54
    s_waitcnt lgkmcnt(0)
    v_add_u32 v8, s55, v8
    v_add_u32 v9, s55, v9
    v_add_u32 v10, s55, v10
    s_barrier
    ds_read_b128 v[16:19], v8 offset:0
    v_mfma_f32_16x16x32_bf16 v[104:107], v[76:79], v[32:35], v[104:107]
    ds_read_b128 v[20:23], v8 offset:2048
    v_mfma_f32_16x16x32_bf16 v[132:135], v[76:79], v[36:39], v[132:135]
    ds_read_b128 v[24:27], v8 offset:4096
    v_mfma_f32_16x16x32_bf16 v[160:163], v[76:79], v[40:43], v[160:163]
    ds_read_b128 v[28:31], v8 offset:6144
    v_mfma_f32_16x16x32_bf16 v[188:191], v[76:79], v[44:47], v[188:191]
    ds_read_b64_tr_b16 v[48:49], v10 offset:0
    v_mfma_f32_16x16x32_bf16 v[108:111], v[80:83], v[32:35], v[108:111]
    ds_read_b64_tr_b16 v[50:51], v10 offset:1792
    v_mfma_f32_16x16x32_bf16 v[136:139], v[80:83], v[36:39], v[136:139]
    ds_read_b64_tr_b16 v[52:53], v10 offset:32
    v_mfma_f32_16x16x32_bf16 v[164:167], v[80:83], v[40:43], v[164:167]
    ds_read_b64_tr_b16 v[54:55], v10 offset:1824
    v_mfma_f32_16x16x32_bf16 v[192:195], v[80:83], v[44:47], v[192:195]
    ds_read_b64_tr_b16 v[56:57], v10 offset:64
    v_mfma_f32_16x16x32_bf16 v[112:115], v[84:87], v[32:35], v[112:115]
    ds_read_b64_tr_b16 v[58:59], v10 offset:1856
    v_mfma_f32_16x16x32_bf16 v[140:143], v[84:87], v[36:39], v[140:143]
    ds_read_b64_tr_b16 v[60:61], v10 offset:96
    v_mfma_f32_16x16x32_bf16 v[168:171], v[84:87], v[40:43], v[168:171]
    ds_read_b64_tr_b16 v[62:63], v10 offset:1888
    v_mfma_f32_16x16x32_bf16 v[196:199], v[84:87], v[44:47], v[196:199]
    ds_read_b64_tr_b16 v[64:65], v10 offset:128
    v_mfma_f32_16x16x32_bf16 v[116:119], v[88:91], v[32:35], v[116:119]
    ds_read_b64_tr_b16 v[66:67], v10 offset:1920
    v_mfma_f32_16x16x32_bf16 v[144:147], v[88:91], v[36:39], v[144:147]
    ds_read_b64_tr_b16 v[68:69], v10 offset:160
    v_mfma_f32_16x16x32_bf16 v[172:175], v[88:91], v[40:43], v[172:175]
    ds_read_b64_tr_b16 v[70:71], v10 offset:1952
    v_mfma_f32_16x16x32_bf16 v[200:203], v[88:91], v[44:47], v[200:203]
    ds_read_b64_tr_b16 v[72:73], v10 offset:192
    v_mfma_f32_16x16x32_bf16 v[120:123], v[92:95], v[32:35], v[120:123]
    ds_read_b64_tr_b16 v[74:75], v10 offset:1984
    v_mfma_f32_16x16x32_bf16 v[148:151], v[92:95], v[36:39], v[148:151]
    v_mfma_f32_16x16x32_bf16 v[176:179], v[92:95], v[40:43], v[176:179]
    v_mfma_f32_16x16x32_bf16 v[204:207], v[92:95], v[44:47], v[204:207]
    v_mfma_f32_16x16x32_bf16 v[124:127], v[96:99], v[32:35], v[124:127]
    v_mfma_f32_16x16x32_bf16 v[152:155], v[96:99], v[36:39], v[152:155]
    v_mfma_f32_16x16x32_bf16 v[180:183], v[96:99], v[40:43], v[180:183]
    v_mfma_f32_16x16x32_bf16 v[208:211], v[96:99], v[44:47], v[208:211]
    v_mfma_f32_16x16x32_bf16 v[128:131], v[100:103], v[32:35], v[128:131]
    v_mfma_f32_16x16x32_bf16 v[156:159], v[100:103], v[36:39], v[156:159]
    v_mfma_f32_16x16x32_bf16 v[184:187], v[100:103], v[40:43], v[184:187]
    v_mfma_f32_16x16x32_bf16 v[212:215], v[100:103], v[44:47], v[212:215]
    s_waitcnt lgkmcnt(0)
    ds_read_b128 v[32:35], v9 offset:0
    v_mfma_f32_16x16x32_bf16 v[104:107], v[48:51], v[16:19], v[104:107]
    ds_read_b128 v[36:39], v9 offset:2048
    v_mfma_f32_16x16x32_bf16 v[132:135], v[48:51], v[20:23], v[132:135]
    ds_read_b128 v[40:43], v9 offset:4096
    v_mfma_f32_16x16x32_bf16 v[160:163], v[48:51], v[24:27], v[160:163]
    ds_read_b128 v[44:47], v9 offset:6144
    v_mfma_f32_16x16x32_bf16 v[188:191], v[48:51], v[28:31], v[188:191]
    ds_read_b64_tr_b16 v[76:77], v10 offset:7168
    v_mfma_f32_16x16x32_bf16 v[108:111], v[52:55], v[16:19], v[108:111]
    ds_read_b64_tr_b16 v[78:79], v10 offset:8960
    v_mfma_f32_16x16x32_bf16 v[136:139], v[52:55], v[20:23], v[136:139]
    ds_read_b64_tr_b16 v[80:81], v10 offset:7200
    v_mfma_f32_16x16x32_bf16 v[164:167], v[52:55], v[24:27], v[164:167]
    ds_read_b64_tr_b16 v[82:83], v10 offset:8992
    v_mfma_f32_16x16x32_bf16 v[192:195], v[52:55], v[28:31], v[192:195]
    ds_read_b64_tr_b16 v[84:85], v10 offset:7232
    v_mfma_f32_16x16x32_bf16 v[112:115], v[56:59], v[16:19], v[112:115]
    ds_read_b64_tr_b16 v[86:87], v10 offset:9024
    v_mfma_f32_16x16x32_bf16 v[140:143], v[56:59], v[20:23], v[140:143]
    ds_read_b64_tr_b16 v[88:89], v10 offset:7264
    v_mfma_f32_16x16x32_bf16 v[168:171], v[56:59], v[24:27], v[168:171]
    ds_read_b64_tr_b16 v[90:91], v10 offset:9056
    v_mfma_f32_16x16x32_bf16 v[196:199], v[56:59], v[28:31], v[196:199]
    ds_read_b64_tr_b16 v[92:93], v10 offset:7296
    v_mfma_f32_16x16x32_bf16 v[116:119], v[60:63], v[16:19], v[116:119]
    ds_read_b64_tr_b16 v[94:95], v10 offset:9088
    v_mfma_f32_16x16x32_bf16 v[144:147], v[60:63], v[20:23], v[144:147]
    ds_read_b64_tr_b16 v[96:97], v10 offset:7328
    v_mfma_f32_16x16x32_bf16 v[172:175], v[60:63], v[24:27], v[172:175]
    ds_read_b64_tr_b16 v[98:99], v10 offset:9120
    v_mfma_f32_16x16x32_bf16 v[200:203], v[60:63], v[28:31], v[200:203]
    ds_read_b64_tr_b16 v[100:101], v10 offset:7360
    v_mfma_f32_16x16x32_bf16 v[120:123], v[64:67], v[16:19], v[120:123]
    ds_read_b64_tr_b16 v[102:103], v10 offset:9152
    v_mfma_f32_16x16x32_bf16 v[148:151], v[64:67], v[20:23], v[148:151]
    v_mfma_f32_16x16x32_bf16 v[176:179], v[64:67], v[24:27], v[176:179]
    v_mfma_f32_16x16x32_bf16 v[204:207], v[64:67], v[28:31], v[204:207]
    v_mfma_f32_16x16x32_bf16 v[124:127], v[68:71], v[16:19], v[124:127]
    v_mfma_f32_16x16x32_bf16 v[152:155], v[68:71], v[20:23], v[152:155]
    v_mfma_f32_16x16x32_bf16 v[180:183], v[68:71], v[24:27], v[180:183]
    v_mfma_f32_16x16x32_bf16 v[208:211], v[68:71], v[28:31], v[208:211]
    v_mfma_f32_16x16x32_bf16 v[128:131], v[72:75], v[16:19], v[128:131]
    v_mfma_f32_16x16x32_bf16 v[156:159], v[72:75], v[20:23], v[156:159]
    v_mfma_f32_16x16x32_bf16 v[184:187], v[72:75], v[24:27], v[184:187]
    v_mfma_f32_16x16x32_bf16 v[212:215], v[72:75], v[28:31], v[212:215]
    s_add_u32 s39, s39, 1
    s_cmp_lt_u32 s39, 10
    s_cbranch_scc1 L1_cloop
    s_waitcnt lgkmcnt(0)
    v_mfma_f32_16x16x32_bf16 v[104:107], v[76:79], v[32:35], v[104:107]
    v_mfma_f32_16x16x32_bf16 v[132:135], v[76:79], v[36:39], v[132:135]
    v_mfma_f32_16x16x32_bf16 v[160:163], v[76:79], v[40:43], v[160:163]
    v_mfma_f32_16x16x32_bf16 v[188:191], v[76:79], v[44:47], v[188:191]
    v_mfma_f32_16x16x32_bf16 v[108:111], v[80:83], v[32:35], v[108:111]
    v_mfma_f32_16x16x32_bf16 v[136:139], v[80:83], v[36:39], v[136:139]
    v_mfma_f32_16x16x32_bf16 v[164:167], v[80:83], v[40:43], v[164:167]
    v_mfma_f32_16x16x32_bf16 v[192:195], v[80:83], v[44:47], v[192:195]
    v_mfma_f32_16x16x32_bf16 v[112:115], v[84:87], v[32:35], v[112:115]
    v_cvt_pk_bf16_f32 v16, v104, v105
    v_cvt_pk_bf16_f32 v17, v106, v107
    ds_write_b64 v3, v[16:17] offset:0
    v_mfma_f32_16x16x32_bf16 v[140:143], v[84:87], v[36:39], v[140:143]
    v_cvt_pk_bf16_f32 v18, v132, v133
    v_cvt_pk_bf16_f32 v19, v134, v135
    ds_write_b64 v3, v[18:19] offset:3840
    v_mfma_f32_16x16x32_bf16 v[168:171], v[84:87], v[40:43], v[168:171]
    v_cvt_pk_bf16_f32 v20, v160, v161
    v_cvt_pk_bf16_f32 v21, v162, v163
    ds_write_b64 v3, v[20:21] offset:7680
    v_mfma_f32_16x16x32_bf16 v[196:199], v[84:87], v[44:47], v[196:199]
    v_cvt_pk_bf16_f32 v22, v188, v189
    v_cvt_pk_bf16_f32 v23, v190, v191
    ds_write_b64 v3, v[22:23] offset:11520
    v_mfma_f32_16x16x32_bf16 v[116:119], v[88:91], v[32:35], v[116:119]
    v_cvt_pk_bf16_f32 v24, v108, v109
    v_cvt_pk_bf16_f32 v25, v110, v111
    ds_write_b64 v3, v[24:25] offset:32
    v_mfma_f32_16x16x32_bf16 v[144:147], v[88:91], v[36:39], v[144:147]
    v_cvt_pk_bf16_f32 v26, v136, v137
    v_cvt_pk_bf16_f32 v27, v138, v139
    ds_write_b64 v3, v[26:27] offset:3872
    v_mfma_f32_16x16x32_bf16 v[172:175], v[88:91], v[40:43], v[172:175]
    v_cvt_pk_bf16_f32 v28, v164, v165
    v_cvt_pk_bf16_f32 v29, v166, v167
    ds_write_b64 v3, v[28:29] offset:7712
    v_mfma_f32_16x16x32_bf16 v[200:203], v[88:91], v[44:47], v[200:203]
    v_cvt_pk_bf16_f32 v30, v192, v193
    v_cvt_pk_bf16_f32 v31, v194, v195
    ds_write_b64 v3, v[30:31] offset:11552
    v_mfma_f32_16x16x32_bf16 v[120:123], v[92:95], v[32:35], v[120:123]
    v_cvt_pk_bf16_f32 v48, v112, v113
    v_cvt_pk_bf16_f32 v49, v114, v115
    ds_write_b64 v3, v[48:49] offset:64
    v_mfma_f32_16x16x32_bf16 v[148:151], v[92:95], v[36:39], v[148:151]
    v_cvt_pk_bf16_f32 v50, v140, v141
    v_cvt_pk_bf16_f32 v51, v142, v143
    ds_write_b64 v3, v[50:51] offset:3904
    v_mfma_f32_16x16x32_bf16 v[176:179], v[92:95], v[40:43], v[176:179]
    v_cvt_pk_bf16_f32 v52, v168, v169
    v_cvt_pk_bf16_f32 v53, v170, v171
    ds_write_b64 v3, v[52:53] offset:7744
    v_mfma_f32_16x16x32_bf16 v[204:207], v[92:95], v[44:47], v[204:207]
    v_cvt_pk_bf16_f32 v54, v196, v197
    v_cvt_pk_bf16_f32 v55, v198, v199
    ds_write_b64 v3, v[54:55] offset:11584
    v_mfma_f32_16x16x32_bf16 v[124:127], v[96:99], v[32:35], v[124:127]
    v_cvt_pk_bf16_f32 v56, v116, v117
    v_cvt_pk_bf16_f32 v57, v118, v119
    ds_write_b64 v3, v[56:57] offset:96
    v_mfma_f32_16x16x32_bf16 v[152:155], v[96:99], v[36:39], v[152:155]
    v_cvt_pk_bf16_f32 v58, v144, v145
    v_cvt_pk_bf16_f32 v59, v146, v147
    ds_write_b64 v3, v[58:59] offset:3936
    v_mfma_f32_16x16x32_bf16 v[180:183], v[96:99], v[40:43], v[180:183]
    v_cvt_pk_bf16_f32 v60, v172, v173
    v_cvt_pk_bf16_f32 v61, v174, v175
    ds_write_b64 v3, v[60:61] offset:7776
    v_mfma_f32_16x16x32_bf16 v[208:211], v[96:99], v[44:47], v[208:211]
    v_cvt_pk_bf16_f32 v62, v200, v201
    v_cvt_pk_bf16_f32 v63, v202, v203
    ds_write_b64 v3, v[62:63] offset:11616
    v_mfma_f32_16x16x32_bf16 v[128:131], v[100:103], v[32:35], v[128:131]
    v_cvt_pk_bf16_f32 v64, v120, v121
    v_cvt_pk_bf16_f32 v65, v122, v123
    ds_write_b64 v3, v[64:65] offset:128
    v_mfma_f32_16x16x32_bf16 v[156:159], v[100:103], v[36:39], v[156:159]
    v_cvt_pk_bf16_f32 v66, v148, v149
    v_cvt_pk_bf16_f32 v67, v150, v151
    ds_write_b64 v3, v[66:67] offset:3968
    v_mfma_f32_16x16x32_bf16 v[184:187], v[100:103], v[40:43], v[184:187]
    v_cvt_pk_bf16_f32 v68, v176, v177
    v_cvt_pk_bf16_f32 v69, v178, v179
    ds_write_b64 v3, v[68:69] offset:7808
    v_mfma_f32_16x16x32_bf16 v[212:215], v[100:103], v[44:47], v[212:215]
    v_cvt_pk_bf16_f32 v70, v204, v205
    v_cvt_pk_bf16_f32 v71, v206, v207
    ds_write_b64 v3, v[70:71] offset:11648
    s_nop 7
    v_cvt_pk_bf16_f32 v72, v124, v125
    v_cvt_pk_bf16_f32 v73, v126, v127
    ds_write_b64 v3, v[72:73] offset:160
    v_cvt_pk_bf16_f32 v74, v152, v153
    v_cvt_pk_bf16_f32 v75, v154, v155
    ds_write_b64 v3, v[74:75] offset:4000
    v_cvt_pk_bf16_f32 v16, v180, v181
    v_cvt_pk_bf16_f32 v17, v182, v183
    ds_write_b64 v3, v[16:17] offset:7840
    v_cvt_pk_bf16_f32 v18, v208, v209
    v_cvt_pk_bf16_f32 v19, v210, v211
    ds_write_b64 v3, v[18:19] offset:11680
    v_cvt_pk_bf16_f32 v20, v128, v129
    v_cvt_pk_bf16_f32 v21, v130, v131
    ds_write_b64 v3, v[20:21] offset:192
    v_cvt_pk_bf16_f32 v22, v156, v157
    v_cvt_pk_bf16_f32 v23, v158, v159
    ds_write_b64 v3, v[22:23] offset:4032
    v_cvt_pk_bf16_f32 v24, v184, v185
    v_cvt_pk_bf16_f32 v25, v186, v187
    ds_write_b64 v3, v[24:25] offset:7872
    v_cvt_pk_bf16_f32 v26, v212, v213
    v_cvt_pk_bf16_f32 v27, v214, v215
    ds_write_b64 v3, v[26:27] offset:11712
    s_waitcnt lgkmcnt(0)
L1_epi:
    v_mul_u32_u24 v10, 4682, v0
    v_lshrrev_b32 v10, 16, v10
    v_mul_u32_u24 v11, 14, v10
    v_sub_u32 v11, v0, v11
    v_mul_u32_u24 v12, 240, v10
    v_lshl_add_u32 v12, v11, 4, v12
    v_add_u32 v12, 45056, v12
    v_mul_u32_u24 v13, 0xd80, v10
    v_lshl_add_u32 v13, v11, 4, v13
    v_mov_b32 v4, 0xc0135761
    v_mov_b32 v5, 0xc0135761
    v_mov_b32 v6, 0xbdd2d3e8
    v_mov_b32 v7, 0xbdd2d3e8
    v_mov_b32 v8, 1.0
    v_mov_b32 v9, 1.0
    s_mul_i32 s44, s38, 3456
    s_add_u32 s44, s44, s37
    s_mov_b32 s39, 0
    s_barrier
    s_cmp_ge_u32 s40, 7
    s_cbranch_scc1 L1_fin
    ds_read_b128 v[64:67], v12
    ds_read_b128 v[68:71], v12 offset:30720
L1_eloop:
    s_waitcnt lgkmcnt(0)
    v_lshlrev_b32 v72, 16, v64
    v_and_b32 v73, 0xffff0000, v64
    v_lshlrev_b32 v74, 16, v65
    v_and_b32 v75, 0xffff0000, v65
    v_lshlrev_b32 v76, 16, v66
    v_and_b32 v77, 0xffff0000, v66
    v_lshlrev_b32 v78, 16, v67
    v_and_b32 v79, 0xffff0000, v67
    v_lshlrev_b32 v80, 16, v68
    v_and_b32 v81, 0xffff0000, v68
    v_lshlrev_b32 v82, 16, v69
    v_and_b32 v83, 0xffff0000, v69
    v_lshlrev_b32 v84, 16, v70
    v_and_b32 v85, 0xffff0000, v70
    v_lshlrev_b32 v86, 16, v71
    v_and_b32 v87, 0xffff0000, v71
    v_add_u32 v12, 7680, v12
    ds_read_b128 v[64:67], v12
    ds_read_b128 v[68:71], v12 offset:30720
    v_pk_mul_f32 v[88:89], v[72:73], v[72:73]
    v_pk_mul_f32 v[90:91], v[74:75], v[74:75]
    v_pk_mul_f32 v[92:93], v[76:77], v[76:77]
    v_pk_mul_f32 v[94:95], v[78:79], v[78:79]
    v_pk_fma_f32 v[88:89], v[88:89], v[6:7], v[4:5]
    v_pk_fma_f32 v[90:91], v[90:91], v[6:7], v[4:5]
    v_pk_fma_f32 v[92:93], v[92:93], v[6:7], v[4:5]
    v_pk_fma_f32 v[94:95], v[94:95], v[6:7], v[4:5]
    v_pk_mul_f32 v[88:89], v[88:89], v[72:73]
    v_pk_mul_f32 v[90:91], v[90:91], v[74:75]
    v_pk_mul_f32 v[92:93], v[92:93], v[76:77]
    v_pk_mul_f32 v[94:95], v[94:95], v[78:79]
    v_exp_f32 v88, v88
    v_exp_f32 v89, v89
    v_exp_f32 v90, v90
    v_exp_f32 v91, v91
    v_exp_f32 v92, v92
    v_exp_f32 v93, v93
    v_exp_f32 v94, v94
    v_exp_f32 v95, v95
    s_nop 0
    v_pk_add_f32 v[88:89], v[88:89], v[8:9]
    v_pk_add_f32 v[90:91], v[90:91], v[8:9]
    v_pk_add_f32 v[92:93], v[92:93], v[8:9]
    v_pk_add_f32 v[94:95], v[94:95], v[8:9]
    v_rcp_f32 v88, v88
    v_rcp_f32 v89, v89
    v_rcp_f32 v90, v90
    v_rcp_f32 v91, v91
    v_rcp_f32 v92, v92
    v_rcp_f32 v93, v93
    v_rcp_f32 v94, v94
    v_rcp_f32 v95, v95
    s_nop 0
    v_pk_mul_f32 v[88:89], v[88:89], v[72:73]
    v_pk_mul_f32 v[90:91], v[90:91], v[74:75]
    v_pk_mul_f32 v[92:93], v[92:93], v[76:77]
    v_pk_mul_f32 v[94:95], v[94:95], v[78:79]
    v_cvt_pk_bf16_f32 v72, v88, v89
    v_cvt_pk_bf16_f32 v74, v90, v91
    v_cvt_pk_bf16_f32 v76, v92, v93
    v_cvt_pk_bf16_f32 v78, v94, v95
    v_lshlrev_b32 v88, 16, v72
    v_and_b32 v89, 0xffff0000, v72
    v_lshlrev_b32 v90, 16, v74
    v_and_b32 v91, 0xffff0000, v74
    v_lshlrev_b32 v92, 16, v76
    v_and_b32 v93, 0xffff0000, v76
    v_lshlrev_b32 v94, 16, v78
    v_and_b32 v95, 0xffff0000, v78
    v_pk_mul_f32 v[88:89], v[88:89], v[80:81]
    v_pk_mul_f32 v[90:91], v[90:91], v[82:83]
    v_pk_mul_f32 v[92:93], v[92:93], v[84:85]
    v_pk_mul_f32 v[94:95], v[94:95], v[86:87]
    v_cvt_pk_bf16_f32 v96, v88, v89
    v_cvt_pk_bf16_f32 v97, v90, v91
    v_cvt_pk_bf16_f32 v98, v92, v93
    v_cvt_pk_bf16_f32 v99, v94, v95
    buffer_store_dwordx4 v[96:99], v13, s[20:23], s44 offen sc1
    s_add_u32 s44, s44, 110592
    s_add_u32 s39, s39, 1
    s_cmp_lt_u32 s39, 4
    s_cbranch_scc1 L1_eloop
L1_fin:
L1_end:
    s_endpgm
    .globl geglu_k2_kernel
    .p2align 8
    .type geglu_k2_kernel,@function
geglu_k2_kernel:
    s_cmp_ge_u32 s2, 256
    s_cbranch_scc1 L2_end
    s_load_dwordx2 s[6:7], s[0:1], 32
    s_load_dwordx2 s[30:31], s[0:1], 48
    s_and_b32 s32, s2, 7
    s_lshr_b32 s33, s2, 3
    s_lshr_b32 s34, s32, 1
    s_and_b32 s35, s32, 1
    s_and_b32 s36, s33, 7
    s_lshl_b32 s34, s34, 3
    s_add_u32 s34, s34, s36
    s_lshr_b32 s36, s33, 3
    s_lshl_b32 s35, s35, 2
    s_add_u32 s35, s35, s36
    s_mul_i32 s37, s35, 160
    s_lshl_b32 s38, s34, 6
    v_lshrrev_b32 v1, 6, v0
    v_and_b32 v2, 63, v0
    s_nop 0
    v_readfirstlane_b32 s40, v1
    s_waitcnt lgkmcnt(0)
    s_mov_b32 s8, s30
    s_and_b32 s9, s31, 0xffff
    s_mov_b32 s10, 7077888
    s_mov_b32 s11, 0x00020000
    s_add_u32 s12, s30, 8388608
    s_addc_u32 s13, s31, 0
    s_and_b32 s13, s13, 0xffff
    s_mov_b32 s14, 2211840
    s_mov_b32 s15, 0x00020000
    s_mov_b32 s20, s6
    s_and_b32 s21, s7, 0xffff
    s_mov_b32 s22, 2621440
    s_mov_b32 s23, 0x00020000
    s_mov_b32 s3, 18432
    s_cmp_lt_u32 s40, 4
    s_cbranch_scc1 L2_compute
    s_sub_u32 s41, s40, 4
    s_lshr_b32 s42, s41, 1
    s_and_b32 s43, s41, 1
    v_lshrrev_b32 v3, 3, v2
    v_and_b32 v4, 7, v2
    v_lshrrev_b32 v5, 4, v2
    s_lshl_b32 s44, s41, 4
    s_add_u32 s44, s44, s38
    v_add_u32 v3, s44, v3
    v_mov_b32 v6, 0xd80
    v_mul_lo_u32 v3, v3, v6
    v_xor_b32 v6, v4, v5
    v_lshlrev_b32 v6, 4, v6
    v_add_u32 v16, v3, v6
    v_xor_b32 v6, 64, v6
    v_add_u32 v17, v3, v6
    v_add_u32 v17, 27648, v17
    s_mul_i32 s44, s42, 5120
    s_mul_i32 s47, s43, 3072
    s_add_u32 s44, s44, s47
    s_mul_i32 s47, s35, 276480
    s_add_u32 s47, s47, s44
    v_lshlrev_b32 v20, 4, v2
    v_add_u32 v20, s47, v20
    v_add_u32 v21, 1024, v20
    v_add_u32 v22, 2048, v20
    s_lshl_b32 s45, s41, 11
    s_add_u32 s46, s44, 8192
    s_mov_b32 s48, 0
    s_mov_b32 s49, 0
    s_mov_b32 s54, 0
    s_mov_b32 s39, 0
    s_cmp_eq_u32 s43, 1
    s_cbranch_scc1 L2_loader_odd
L2_pla:
    s_add_u32 m0, s45, 0
    s_nop 0
    buffer_load_dwordx4 v16, s[8:11], s48 offen lds
    s_add_u32 m0, s45, 1024
    s_nop 0
    buffer_load_dwordx4 v17, s[8:11], s48 offen lds
    s_add_u32 m0, s46, 0
    s_nop 0
    buffer_load_dwordx4 v20, s[12:15], s49 offen lds
    s_add_u32 m0, s46, 1024
    s_nop 0
    buffer_load_dwordx4 v21, s[12:15], s49 offen lds
    s_add_u32 m0, s46, 2048
    s_nop 0
    buffer_load_dwordx4 v22, s[12:15], s49 offen lds
    s_add_u32 s48, s48, 128
    s_add_u32 s49, s49, 10240
    s_add_u32 s54, s54, 1
    s_cmp_eq_u32 s54, 8
    s_cselect_b32 s55, -129024, s3
    s_cselect_b32 s54, 0, s54
    s_add_u32 s45, s45, s55
    s_add_u32 s46, s46, s55
    s_add_u32 s39, s39, 1
    s_cmp_lt_u32 s39, 7
    s_cbranch_scc1 L2_pla
    s_mov_b32 s39, 0
L2_mla:
    s_waitcnt vmcnt(30)
    s_barrier
    s_add_u32 m0, s45, 0
    s_nop 0
    buffer_load_dwordx4 v16, s[8:11], s48 offen lds
    s_add_u32 m0, s45, 1024
    s_nop 0
    buffer_load_dwordx4 v17, s[8:11], s48 offen lds
    s_add_u32 m0, s46, 0
    s_nop 0
    buffer_load_dwordx4 v20, s[12:15], s49 offen lds
    s_add_u32 m0, s46, 1024
    s_nop 0
    buffer_load_dwordx4 v21, s[12:15], s49 offen lds
    s_add_u32 m0, s46, 2048
    s_nop 0
    buffer_load_dwordx4 v22, s[12:15], s49 offen lds
    s_add_u32 s48, s48, 128
    s_add_u32 s49, s49, 10240
    s_add_u32 s54, s54, 1
    s_cmp_eq_u32 s54, 8
    s_cselect_b32 s55, -129024, s3
    s_cselect_b32 s54, 0, s54
    s_add_u32 s45, s45, s55
    s_add_u32 s46, s46, s55
    s_add_u32 s39, s39, 1
    s_cmp_lt_u32 s39, 20
    s_cbranch_scc1 L2_mla
    s_waitcnt vmcnt(30)
    s_barrier
    s_waitcnt vmcnt(25)
    s_barrier
    s_waitcnt vmcnt(20)
    s_barrier
    s_waitcnt vmcnt(15)
    s_barrier
    s_waitcnt vmcnt(10)
    s_barrier
    s_waitcnt vmcnt(5)
    s_barrier
    s_waitcnt vmcnt(0)
    s_barrier
    s_branch L2_end
L2_loader_odd:
L2_plb:
    s_add_u32 m0, s45, 0
    s_nop 0
    buffer_load_dwordx4 v16, s[8:11], s48 offen lds
    s_add_u32 m0, s45, 1024
    s_nop 0
    buffer_load_dwordx4 v17, s[8:11], s48 offen lds
    s_add_u32 m0, s46, 0
    s_nop 0
    buffer_load_dwordx4 v20, s[12:15], s49 offen lds
    s_add_u32 m0, s46, 1024
    s_nop 0
    buffer_load_dwordx4 v21, s[12:15], s49 offen lds
    s_add_u32 s48, s48, 128
    s_add_u32 s49, s49, 10240
    s_add_u32 s54, s54, 1
    s_cmp_eq_u32 s54, 8
    s_cselect_b32 s55, -129024, s3
    s_cselect_b32 s54, 0, s54
    s_add_u32 s45, s45, s55
    s_add_u32 s46, s46, s55
    s_add_u32 s39, s39, 1
    s_cmp_lt_u32 s39, 7
    s_cbranch_scc1 L2_plb
    s_mov_b32 s39, 0
L2_mlb:
    s_waitcnt vmcnt(24)
    s_barrier
    s_add_u32 m0, s45, 0
    s_nop 0
    buffer_load_dwordx4 v16, s[8:11], s48 offen lds
    s_add_u32 m0, s45, 1024
    s_nop 0
    buffer_load_dwordx4 v17, s[8:11], s48 offen lds
    s_add_u32 m0, s46, 0
    s_nop 0
    buffer_load_dwordx4 v20, s[12:15], s49 offen lds
    s_add_u32 m0, s46, 1024
    s_nop 0
    buffer_load_dwordx4 v21, s[12:15], s49 offen lds
    s_add_u32 s48, s48, 128
    s_add_u32 s49, s49, 10240
    s_add_u32 s54, s54, 1
    s_cmp_eq_u32 s54, 8
    s_cselect_b32 s55, -129024, s3
    s_cselect_b32 s54, 0, s54
    s_add_u32 s45, s45, s55
    s_add_u32 s46, s46, s55
    s_add_u32 s39, s39, 1
    s_cmp_lt_u32 s39, 20
    s_cbranch_scc1 L2_mlb
    s_waitcnt vmcnt(24)
    s_barrier
    s_waitcnt vmcnt(20)
    s_barrier
    s_waitcnt vmcnt(16)
    s_barrier
    s_waitcnt vmcnt(12)
    s_barrier
    s_waitcnt vmcnt(8)
    s_barrier
    s_waitcnt vmcnt(4)
    s_barrier
    s_waitcnt vmcnt(0)
    s_barrier
    s_branch L2_end
L2_compute:
    v_and_b32 v30, 15, v2
    v_lshrrev_b32 v31, 4, v2
    v_lshrrev_b32 v32, 1, v30
    v_xor_b32 v32, v31, v32
    v_lshlrev_b32 v32, 4, v32
    v_lshl_add_u32 v32, v30, 7, v32
    s_lshl_b32 s43, s40, 11
    v_add_u32 v4, s43, v32
    v_xor_b32 v5, 64, v4
    v_lshrrev_b32 v33, 1, v31
    v_lshlrev_b32 v33, 4, v33
    v_and_b32 v34, 1, v31
    v_lshl_add_u32 v33, v34, 2, v33
    v_bfe_u32 v34, v2, 2, 2
    v_add_u32 v33, v33, v34
    v_mul_u32_u24 v33, 160, v33
    v_and_b32 v34, 3, v2
    v_lshl_add_u32 v33, v34, 3, v33
    v_add_u32 v6, 8192, v33
    s_lshl_b32 s43, s40, 4
    v_add_u32 v3, s43, v30
    v_mul_u32_u24 v3, 0x500, v3
    v_lshl_add_u32 v3, v31, 3, v3
    s_mul_i32 s44, s38, 1280
    s_add_u32 s44, s44, s37
    s_mov_b32 s54, 0
    s_mov_b32 s39, 0
    v_mov_b32 v136, 0
    v_mov_b32 v137, 0
    v_mov_b32 v138, 0
    v_mov_b32 v139, 0
    v_mov_b32 v140, 0
    v_mov_b32 v141, 0
    v_mov_b32 v142, 0
    v_mov_b32 v143, 0
    v_mov_b32 v144, 0
    v_mov_b32 v145, 0
    v_mov_b32 v146, 0
    v_mov_b32 v147, 0
    v_mov_b32 v148, 0
    v_mov_b32 v149, 0
    v_mov_b32 v150, 0
    v_mov_b32 v151, 0
    v_mov_b32 v152, 0
    v_mov_b32 v153, 0
    v_mov_b32 v154, 0
    v_mov_b32 v155, 0
    s_barrier
    ds_read_b128 v[40:43], v4
    ds_read_b64_tr_b16 v[48:49], v6 offset:0
    ds_read_b64_tr_b16 v[50:51], v6 offset:1280
    ds_read_b64_tr_b16 v[52:53], v6 offset:32
    ds_read_b64_tr_b16 v[54:55], v6 offset:1312
    ds_read_b64_tr_b16 v[56:57], v6 offset:64
    ds_read_b64_tr_b16 v[58:59], v6 offset:1344
    ds_read_b64_tr_b16 v[60:61], v6 offset:96
    ds_read_b64_tr_b16 v[62:63], v6 offset:1376
    ds_read_b64_tr_b16 v[64:65], v6 offset:128
    ds_read_b64_tr_b16 v[66:67], v6 offset:1408
    ds_read_b128 v[44:47], v5
    ds_read_b64_tr_b16 v[68:69], v6 offset:5120
    ds_read_b64_tr_b16 v[70:71], v6 offset:6400
    ds_read_b64_tr_b16 v[72:73], v6 offset:5152
    ds_read_b64_tr_b16 v[74:75], v6 offset:6432
    ds_read_b64_tr_b16 v[76:77], v6 offset:5184
    ds_read_b64_tr_b16 v[78:79], v6 offset:6464
    ds_read_b64_tr_b16 v[80:81], v6 offset:5216
    ds_read_b64_tr_b16 v[82:83], v6 offset:6496
    ds_read_b64_tr_b16 v[84:85], v6 offset:5248
    ds_read_b64_tr_b16 v[86:87], v6 offset:6528
L2_cloop:
    s_add_u32 s54, s54, 1
    s_cmp_eq_u32 s54, 8
    s_cselect_b32 s55, -129024, s3
    s_cselect_b32 s54, 0, s54
    s_waitcnt lgkmcnt(0)
    v_add_u32 v4, s55, v4
    v_add_u32 v5, s55, v5
    v_add_u32 v6, s55, v6
    s_barrier
    ds_read_b128 v[88:91], v4
    ds_read_b64_tr_b16 v[96:97], v6 offset:0
    v_mfma_f32_16x16x32_bf16 v[136:139], v[48:51], v[40:43], v[136:139]
    ds_read_b64_tr_b16 v[98:99], v6 offset:1280
    ds_read_b64_tr_b16 v[100:101], v6 offset:32
    v_mfma_f32_16x16x32_bf16 v[140:143], v[52:55], v[40:43], v[140:143]
    ds_read_b64_tr_b16 v[102:103], v6 offset:1312
    ds_read_b64_tr_b16 v[104:105], v6 offset:64
    v_mfma_f32_16x16x32_bf16 v[144:147], v[56:59], v[40:43], v[144:147]
    ds_read_b64_tr_b16 v[106:107], v6 offset:1344
    ds_read_b64_tr_b16 v[108:109], v6 offset:96
    v_mfma_f32_16x16x32_bf16 v[148:151], v[60:63], v[40:43], v[148:151]
    ds_read_b64_tr_b16 v[110:111], v6 offset:1376
    ds_read_b64_tr_b16 v[112:113], v6 offset:128
    v_mfma_f32_16x16x32_bf16 v[152:155], v[64:67], v[40:43], v[152:155]
    ds_read_b64_tr_b16 v[114:115], v6 offset:1408
    ds_read_b128 v[92:95], v5
    v_mfma_f32_16x16x32_bf16 v[136:139], v[68:71], v[44:47], v[136:139]
    ds_read_b64_tr_b16 v[116:117], v6 offset:5120
    ds_read_b64_tr_b16 v[118:119], v6 offset:6400
    v_mfma_f32_16x16x32_bf16 v[140:143], v[72:75], v[44:47], v[140:143]
    ds_read_b64_tr_b16 v[120:121], v6 offset:5152
    ds_read_b64_tr_b16 v[122:123], v6 offset:6432
    v_mfma_f32_16x16x32_bf16 v[144:147], v[76:79], v[44:47], v[144:147]
    ds_read_b64_tr_b16 v[124:125], v6 offset:5184
    ds_read_b64_tr_b16 v[126:127], v6 offset:6464
    v_mfma_f32_16x16x32_bf16 v[148:151], v[80:83], v[44:47], v[148:151]
    ds_read_b64_tr_b16 v[128:129], v6 offset:5216
    ds_read_b64_tr_b16 v[130:131], v6 offset:6496
    v_mfma_f32_16x16x32_bf16 v[152:155], v[84:87], v[44:47], v[152:155]
    ds_read_b64_tr_b16 v[132:133], v6 offset:5248
    ds_read_b64_tr_b16 v[134:135], v6 offset:6528
    s_add_u32 s54, s54, 1
    s_cmp_eq_u32 s54, 8
    s_cselect_b32 s55, -129024, s3
    s_cselect_b32 s54, 0, s54
    s_waitcnt lgkmcnt(0)
    v_add_u32 v4, s55, v4
    v_add_u32 v5, s55, v5
    v_add_u32 v6, s55, v6
    s_barrier
    ds_read_b128 v[40:43], v4
    ds_read_b64_tr_b16 v[48:49], v6 offset:0
    v_mfma_f32_16x16x32_bf16 v[136:139], v[96:99], v[88:91], v[136:139]
    ds_read_b64_tr_b16 v[50:51], v6 offset:1280
    ds_read_b64_tr_b16 v[52:53], v6 offset:32
    v_mfma_f32_16x16x32_bf16 v[140:143], v[100:103], v[88:91], v[140:143]
    ds_read_b64_tr_b16 v[54:55], v6 offset:1312
    ds_read_b64_tr_b16 v[56:57], v6 offset:64
    v_mfma_f32_16x16x32_bf16 v[144:147], v[104:107], v[88:91], v[144:147]
    ds_read_b64_tr_b16 v[58:59], v6 offset:1344
    ds_read_b64_tr_b16 v[60:61], v6 offset:96
    v_mfma_f32_16x16x32_bf16 v[148:151], v[108:111], v[88:91], v[148:151]
    ds_read_b64_tr_b16 v[62:63], v6 offset:1376
    ds_read_b64_tr_b16 v[64:65], v6 offset:128
    v_mfma_f32_16x16x32_bf16 v[152:155], v[112:115], v[88:91], v[152:155]
    ds_read_b64_tr_b16 v[66:67], v6 offset:1408
    ds_read_b128 v[44:47], v5
    v_mfma_f32_16x16x32_bf16 v[136:139], v[116:119], v[92:95], v[136:139]
    ds_read_b64_tr_b16 v[68:69], v6 offset:5120
    ds_read_b64_tr_b16 v[70:71], v6 offset:6400
    v_mfma_f32_16x16x32_bf16 v[140:143], v[120:123], v[92:95], v[140:143]
    ds_read_b64_tr_b16 v[72:73], v6 offset:5152
    ds_read_b64_tr_b16 v[74:75], v6 offset:6432
    v_mfma_f32_16x16x32_bf16 v[144:147], v[124:127], v[92:95], v[144:147]
    ds_read_b64_tr_b16 v[76:77], v6 offset:5184
    ds_read_b64_tr_b16 v[78:79], v6 offset:6464
    v_mfma_f32_16x16x32_bf16 v[148:151], v[128:131], v[92:95], v[148:151]
    ds_read_b64_tr_b16 v[80:81], v6 offset:5216
    ds_read_b64_tr_b16 v[82:83], v6 offset:6496
    v_mfma_f32_16x16x32_bf16 v[152:155], v[132:135], v[92:95], v[152:155]
    ds_read_b64_tr_b16 v[84:85], v6 offset:5248
    ds_read_b64_tr_b16 v[86:87], v6 offset:6528
    s_add_u32 s39, s39, 1
    s_cmp_lt_u32 s39, 13
    s_cbranch_scc1 L2_cloop
    s_waitcnt lgkmcnt(0)
    v_mfma_f32_16x16x32_bf16 v[136:139], v[48:51], v[40:43], v[136:139]
    v_mfma_f32_16x16x32_bf16 v[140:143], v[52:55], v[40:43], v[140:143]
    v_mfma_f32_16x16x32_bf16 v[144:147], v[56:59], v[40:43], v[144:147]
    v_mfma_f32_16x16x32_bf16 v[148:151], v[60:63], v[40:43], v[148:151]
    v_mfma_f32_16x16x32_bf16 v[152:155], v[64:67], v[40:43], v[152:155]
    v_mfma_f32_16x16x32_bf16 v[136:139], v[68:71], v[44:47], v[136:139]
    v_mfma_f32_16x16x32_bf16 v[140:143], v[72:75], v[44:47], v[140:143]
    v_mfma_f32_16x16x32_bf16 v[144:147], v[76:79], v[44:47], v[144:147]
    v_mfma_f32_16x16x32_bf16 v[148:151], v[80:83], v[44:47], v[148:151]
    v_mfma_f32_16x16x32_bf16 v[152:155], v[84:87], v[44:47], v[152:155]
    s_nop 7
    v_cvt_pk_bf16_f32 v40, v136, v137
    v_cvt_pk_bf16_f32 v41, v138, v139
    buffer_store_dwordx2 v[40:41], v3, s[20:23], s44 offen offset:0
    v_cvt_pk_bf16_f32 v42, v140, v141
    v_cvt_pk_bf16_f32 v43, v142, v143
    buffer_store_dwordx2 v[42:43], v3, s[20:23], s44 offen offset:32
    v_cvt_pk_bf16_f32 v44, v144, v145
    v_cvt_pk_bf16_f32 v45, v146, v147
    buffer_store_dwordx2 v[44:45], v3, s[20:23], s44 offen offset:64
    v_cvt_pk_bf16_f32 v46, v148, v149
    v_cvt_pk_bf16_f32 v47, v150, v151
    buffer_store_dwordx2 v[46:47], v3, s[20:23], s44 offen offset:96
    v_cvt_pk_bf16_f32 v48, v152, v153
    v_cvt_pk_bf16_f32 v49, v154, v155
    buffer_store_dwordx2 v[48:49], v3, s[20:23], s44 offen offset:128
L2_end:
    s_endpgm
.section .rodata,"a"
.p2align 6
.amdhsa_kernel geglu_k1_kernel
  .amdhsa_next_free_vgpr 224
  .amdhsa_next_free_sgpr 102
  .amdhsa_accum_offset 224
  .amdhsa_group_segment_fixed_size 0
  .amdhsa_kernarg_size 56
  .amdhsa_user_sgpr_count 2
  .amdhsa_user_sgpr_kernarg_segment_ptr 1
  .amdhsa_system_sgpr_workgroup_id_x 1
.end_amdhsa_kernel
.p2align 6
.amdhsa_kernel geglu_k2_kernel
  .amdhsa_next_free_vgpr 160
  .amdhsa_next_free_sgpr 102
  .amdhsa_accum_offset 160
  .amdhsa_group_segment_fixed_size 0
  .amdhsa_kernarg_size 56
  .amdhsa_user_sgpr_count 2
  .amdhsa_user_sgpr_kernarg_segment_ptr 1
  .amdhsa_system_sgpr_workgroup_id_x 1
.end_amdhsa_kernel
```
